```python
import torch

def _softmax(x, axis=-1):
    return torch.softmax(x, dim=axis)
def _gelu(x):
    return torch.nn.functional.gelu(x, approximate="tanh")
def _silu(x):
    return torch.nn.functional.silu(x)
def _sigmoid(x):
    return torch.sigmoid(x)
def _layernorm(x, axis=-1, eps=1e-5):
    m = x.mean(dim=axis, keepdim=True)
    v = x.var(dim=axis, keepdim=True, unbiased=False)
    return (x - m) / torch.sqrt(v + eps)
def _scatter_add(tgt, idx, src, axis=0):
    return tgt.clone().index_add_(axis, idx, src)
def _segment_sum(src, seg, n):
    out = torch.zeros((n,) + src.shape[1:], dtype=src.dtype)
    return out.index_add_(0, seg, src)
def _pad(x, pw):
    flat = tuple(v for pair in reversed(pw) for v in pair)
    return torch.nn.functional.pad(x, flat)

kernel_name = 'standalone__low_rank_proj_linformer__decode'

def setup_inputs():

    _w = (lambda a: (lambda t: t.to(torch.bfloat16) if t.is_floating_point() else t)(torch.as_tensor(a)))
    B, H, Sq, Skv, Dh, R = 4, 16, 1, 8192, 256, 64
    return {
        "q": _w((lambda *s: torch.randn(*s, dtype=torch.bfloat16) * 0.8)(B, H, Sq, Dh)),
        "k": _w((lambda *s: torch.randn(*s, dtype=torch.bfloat16) * 0.8)(B, H, Skv, Dh)),
        "v": _w((lambda *s: torch.randn(*s, dtype=torch.bfloat16) * 0.05)(B, H, Skv, Dh)),
        "e_proj": _w((lambda *s: torch.randn(*s, dtype=torch.bfloat16) * 0.8)(R, Skv) * (Skv ** -0.5)),
        "f_proj": _w((lambda *s: torch.randn(*s, dtype=torch.bfloat16) * 0.05)(R, Skv) * (Skv ** -0.5)),
    }

def reference(q, k, v, e_proj, f_proj):
    B, H, Sq, Dh = q.shape
    kp = torch.einsum("rn,bhnd->bhrd", e_proj, k)
    vp = torch.einsum("rn,bhnd->bhrd", f_proj, v)
    scores = torch.einsum("bhqd,bhrd->bhqr", q, kp) * (Dh ** -0.5)
    p = _softmax(scores, axis=-1)
    o = torch.einsum("bhqr,bhrd->bhqd", p, vp)
    return o
```

```asm
; @launch grid=(256,1,1) block=(384,1,1) lds=120576
.amdgcn_target "amdgcn-amd-amdhsa--gfx950"
.text
.globl standalone__low_rank_proj_linformer__decode_kernel
.p2align 8
.type standalone__low_rank_proj_linformer__decode_kernel,@function
standalone__low_rank_proj_linformer__decode_kernel:
  s_cmp_ge_u32 s2, 256
  s_cbranch_scc1 L_end
  s_load_dwordx8 s[4:11], s[0:1], 8
  v_lshrrev_b32 v2, 6, v0
  v_and_b32 v1, 63, v0
  s_lshr_b32 s20, s2, 2
  v_readfirstlane_b32 s3, v2
  s_and_b32 s21, s2, 3
  s_cmp_lt_u32 s3, 4
  s_cbranch_scc1 L_consumer
  s_cmp_eq_u32 s3, 5
  s_cbranch_scc1 L_helper
  s_lshl_b32 s23, s20, 22
  s_lshl_b32 s24, s21, 20
  s_lshl_b32 s25, s21, 12
  s_lshr_b32 s34, s2, 3
  s_and_b32 s34, s34, 31
  s_lshl_b32 s29, s34, 7
  s_add_u32 s29, s29, s25
  s_lshl_b32 s28, s34, 15
  s_add_u32 s28, s28, s24
  s_mov_b32 s14, 0x400000
  s_mov_b32 s15, 0x20000
  s_mov_b32 s18, 0x100000
  s_mov_b32 s19, 0x20000
  v_lshrrev_b32 v10, 5, v1
  v_and_b32 v11, 31, v1
  v_lshlrev_b32 v12, 2, v10
  v_xor_b32 v13, v11, v12
  v_lshlrev_b32 v13, 4, v13
  v_lshlrev_b32 v14, 9, v10
  v_add_u32 v2, v13, v14
  v_xor_b32 v3, 0x80, v2
  v_lshrrev_b32 v10, 3, v1
  v_lshlrev_b32 v11, 14, v10
  v_and_b32 v12, 7, v1
  v_lshrrev_b32 v13, 4, v1
  v_xor_b32 v14, v12, v13
  v_xor_b32 v15, 4, v14
  v_lshl_add_u32 v4, v14, 4, v11
  v_lshl_add_u32 v5, v15, 4, v11
  v_mov_b32 v6, 2304
  v_lshl_add_u32 v6, v1, 2, v6
  v_and_b32 v7, 3, v1
  v_lshlrev_b32 v7, 8, v7
  v_add_u32 v7, 2816, v7
  s_mov_b32 s27, 5888
  s_mov_b32 s26, 87808
  s_waitcnt lgkmcnt(0)
  s_add_u32 s12, s4, s23
  s_addc_u32 s13, s5, 0
  s_mov_b32 s16, s8
  s_mov_b32 s17, s9
  s_add_u32 m0, s27, 0
  s_add_u32 s31, s28, 0
  buffer_load_dwordx4 v2, s[12:15], s31 offen offset:0 nt lds
  buffer_load_dwordx4 v3, s[12:15], s31 offen offset:1024 nt lds
  buffer_load_dwordx4 v2, s[12:15], s31 offen offset:2048 nt lds
  buffer_load_dwordx4 v3, s[12:15], s31 offen offset:3072 nt lds
  s_add_u32 m0, s26, 0
  s_add_u32 s31, s29, 0
  buffer_load_dwordx4 v4, s[16:19], s31 offen lds
  s_add_u32 m0, s26, 1024
  s_add_u32 s31, s29, 131072
  buffer_load_dwordx4 v5, s[16:19], s31 offen lds
  s_add_u32 m0, s26, 2048
  s_add_u32 s31, s29, 262144
  buffer_load_dwordx4 v4, s[16:19], s31 offen lds
  s_add_u32 m0, s26, 3072
  s_add_u32 s31, s29, 393216
  buffer_load_dwordx4 v5, s[16:19], s31 offen lds
  s_add_u32 m0, s26, 4096
  s_add_u32 s31, s29, 524288
  buffer_load_dwordx4 v4, s[16:19], s31 offen lds
  s_add_u32 m0, s26, 5120
  s_add_u32 s31, s29, 655360
  buffer_load_dwordx4 v5, s[16:19], s31 offen lds
  s_add_u32 m0, s26, 6144
  s_add_u32 s31, s29, 786432
  buffer_load_dwordx4 v4, s[16:19], s31 offen lds
  s_add_u32 m0, s26, 7168
  s_add_u32 s31, s29, 917504
  buffer_load_dwordx4 v5, s[16:19], s31 offen lds
  s_add_u32 s26, s26, 8192
  s_cmp_ge_u32 s26, 120576
  s_cselect_b32 s26, 87808, s26
  s_add_u32 s44, s34, 1
  s_and_b32 s46, s44, 31
  s_lshl_b32 s29, s46, 7
  s_lshl_b32 s47, s21, 12
  s_add_u32 s29, s29, s47
  s_lshl_b32 s45, s46, 15
  s_lshl_b32 s47, s21, 20
  s_add_u32 s45, s45, s47
  s_mov_b32 s33, 0
  s_mov_b32 s35, 0
  v_mov_b32 v8, 0
  s_add_u32 m0, s26, 0
  s_add_u32 s31, s29, 0
  buffer_load_dwordx4 v4, s[16:19], s31 offen lds
  s_add_u32 m0, s27, 4096
  s_add_u32 s31, s28, 4096
  buffer_load_dwordx4 v2, s[12:15], s31 offen offset:0 nt lds
  buffer_load_dwordx4 v3, s[12:15], s31 offen offset:1024 nt lds
  buffer_load_dwordx4 v2, s[12:15], s31 offen offset:2048 nt lds
  buffer_load_dwordx4 v3, s[12:15], s31 offen offset:3072 nt lds
  s_add_u32 m0, s26, 1024
  s_add_u32 s31, s29, 131072
  buffer_load_dwordx4 v5, s[16:19], s31 offen lds
  s_add_u32 m0, s27, 8192
  s_add_u32 s31, s28, 8192
  buffer_load_dwordx4 v2, s[12:15], s31 offen offset:0 nt lds
  buffer_load_dwordx4 v3, s[12:15], s31 offen offset:1024 nt lds
  buffer_load_dwordx4 v2, s[12:15], s31 offen offset:2048 nt lds
  buffer_load_dwordx4 v3, s[12:15], s31 offen offset:3072 nt lds
  s_add_u32 m0, s26, 2048
  s_add_u32 s31, s29, 262144
  buffer_load_dwordx4 v4, s[16:19], s31 offen lds
  s_add_u32 m0, s27, 12288
  s_add_u32 s31, s28, 12288
  buffer_load_dwordx4 v2, s[12:15], s31 offen offset:0 nt lds
  buffer_load_dwordx4 v3, s[12:15], s31 offen offset:1024 nt lds
  buffer_load_dwordx4 v2, s[12:15], s31 offen offset:2048 nt lds
  buffer_load_dwordx4 v3, s[12:15], s31 offen offset:3072 nt lds
  s_add_u32 m0, s26, 3072
  s_add_u32 s31, s29, 393216
  buffer_load_dwordx4 v5, s[16:19], s31 offen lds
  s_mov_b32 s36, 0
  s_add_u32 s27, s27, 16384
  s_cmp_ge_u32 s27, 87808
  s_cselect_b32 s27, 5888, s27
  s_add_u32 s28, s28, 16384
  s_mov_b32 s33, 1
  s_branch L_lodd
L_lloop:
  s_cmp_lg_u32 s33, 2
  s_cbranch_scc1 L_lnb
  s_barrier
L_lnb:
  s_add_u32 s44, s44, 1
  s_and_b32 s46, s44, 31
  s_lshl_b32 s29, s46, 7
  s_lshl_b32 s47, s21, 12
  s_add_u32 s29, s29, s47
  s_lshl_b32 s45, s46, 15
  s_lshl_b32 s47, s21, 20
  s_add_u32 s45, s45, s47
  s_cmp_lt_u32 s33, 5
  s_cbranch_scc1 L_fc2
  s_sub_u32 s37, s33, 4
  s_cmp_ge_u32 s36, s37
  s_cbranch_scc1 L_fc2
  s_mov_b32 s38, 0
L_fc1:
  ds_read_b32 v9, v7
  s_waitcnt lgkmcnt(0)
  v_readlane_b32 s40, v9, 0
  v_readlane_b32 s41, v9, 1
  v_readlane_b32 s42, v9, 2
  v_readlane_b32 s43, v9, 3
  s_min_u32 s40, s40, s41
  s_min_u32 s42, s42, s43
  s_min_u32 s36, s40, s42
  s_cmp_ge_u32 s36, s37
  s_cbranch_scc1 L_fc2
  s_add_u32 s38, s38, 1
  s_cmp_lt_u32 s38, 4194304
  s_cbranch_scc1 L_fc1
L_fc2:
  s_waitcnt vmcnt(22)
  s_add_u32 m0, s27, 0
  s_add_u32 s31, s28, 0
  buffer_load_dwordx4 v2, s[12:15], s31 offen offset:0 nt lds
  buffer_load_dwordx4 v3, s[12:15], s31 offen offset:1024 nt lds
  buffer_load_dwordx4 v2, s[12:15], s31 offen offset:2048 nt lds
  buffer_load_dwordx4 v3, s[12:15], s31 offen offset:3072 nt lds
  s_add_u32 m0, s26, 0
  s_add_u32 s31, s29, 0
  buffer_load_dwordx4 v4, s[16:19], s31 offen lds
  s_waitcnt vmcnt(22)
  s_cmp_lt_u32 s33, 2
  s_cbranch_scc1 L_ns3
  v_add_u32 v8, 1, v8
  ds_write_b32 v6, v8
L_ns3:
  s_add_u32 m0, s27, 4096
  s_add_u32 s31, s28, 4096
  buffer_load_dwordx4 v2, s[12:15], s31 offen offset:0 nt lds
  buffer_load_dwordx4 v3, s[12:15], s31 offen offset:1024 nt lds
  buffer_load_dwordx4 v2, s[12:15], s31 offen offset:2048 nt lds
  buffer_load_dwordx4 v3, s[12:15], s31 offen offset:3072 nt lds
  s_add_u32 m0, s26, 1024
  s_add_u32 s31, s29, 131072
  buffer_load_dwordx4 v5, s[16:19], s31 offen lds
  s_waitcnt vmcnt(22)
  s_add_u32 m0, s27, 8192
  s_add_u32 s31, s28, 8192
  buffer_load_dwordx4 v2, s[12:15], s31 offen offset:0 nt lds
  buffer_load_dwordx4 v3, s[12:15], s31 offen offset:1024 nt lds
  buffer_load_dwordx4 v2, s[12:15], s31 offen offset:2048 nt lds
  buffer_load_dwordx4 v3, s[12:15], s31 offen offset:3072 nt lds
  s_add_u32 m0, s26, 2048
  s_add_u32 s31, s29, 262144
  buffer_load_dwordx4 v4, s[16:19], s31 offen lds
  s_waitcnt vmcnt(22)
  s_add_u32 m0, s27, 12288
  s_add_u32 s31, s28, 12288
  buffer_load_dwordx4 v2, s[12:15], s31 offen offset:0 nt lds
  buffer_load_dwordx4 v3, s[12:15], s31 offen offset:1024 nt lds
  buffer_load_dwordx4 v2, s[12:15], s31 offen offset:2048 nt lds
  buffer_load_dwordx4 v3, s[12:15], s31 offen offset:3072 nt lds
  s_add_u32 m0, s26, 3072
  s_add_u32 s31, s29, 393216
  buffer_load_dwordx4 v5, s[16:19], s31 offen lds
  s_add_u32 s27, s27, 16384
  s_cmp_ge_u32 s27, 87808
  s_cselect_b32 s27, 5888, s27
  s_add_u32 s28, s28, 16384
  s_add_u32 s33, s33, 1
L_lodd:
  s_cmp_lt_u32 s33, 5
  s_cbranch_scc1 L_fc5
  s_sub_u32 s37, s33, 4
  s_cmp_ge_u32 s36, s37
  s_cbranch_scc1 L_fc5
  s_mov_b32 s38, 0
L_fc4:
  ds_read_b32 v9, v7
  s_waitcnt lgkmcnt(0)
  v_readlane_b32 s40, v9, 0
  v_readlane_b32 s41, v9, 1
  v_readlane_b32 s42, v9, 2
  v_readlane_b32 s43, v9, 3
  s_min_u32 s40, s40, s41
  s_min_u32 s42, s42, s43
  s_min_u32 s36, s40, s42
  s_cmp_ge_u32 s36, s37
  s_cbranch_scc1 L_fc5
  s_add_u32 s38, s38, 1
  s_cmp_lt_u32 s38, 4194304
  s_cbranch_scc1 L_fc4
L_fc5:
  s_waitcnt vmcnt(22)
  s_add_u32 m0, s27, 0
  s_add_u32 s31, s28, 0
  buffer_load_dwordx4 v2, s[12:15], s31 offen offset:0 nt lds
  buffer_load_dwordx4 v3, s[12:15], s31 offen offset:1024 nt lds
  buffer_load_dwordx4 v2, s[12:15], s31 offen offset:2048 nt lds
  buffer_load_dwordx4 v3, s[12:15], s31 offen offset:3072 nt lds
  s_add_u32 m0, s26, 4096
  s_add_u32 s31, s29, 524288
  buffer_load_dwordx4 v4, s[16:19], s31 offen lds
  s_waitcnt vmcnt(22)
  s_cmp_lt_u32 s33, 2
  s_cbranch_scc1 L_ns6
  v_add_u32 v8, 1, v8
  ds_write_b32 v6, v8
L_ns6:
  s_add_u32 m0, s27, 4096
  s_add_u32 s31, s28, 4096
  buffer_load_dwordx4 v2, s[12:15], s31 offen offset:0 nt lds
  buffer_load_dwordx4 v3, s[12:15], s31 offen offset:1024 nt lds
  buffer_load_dwordx4 v2, s[12:15], s31 offen offset:2048 nt lds
  buffer_load_dwordx4 v3, s[12:15], s31 offen offset:3072 nt lds
  s_add_u32 m0, s26, 5120
  s_add_u32 s31, s29, 655360
  buffer_load_dwordx4 v5, s[16:19], s31 offen lds
  s_waitcnt vmcnt(22)
  s_add_u32 m0, s27, 8192
  s_add_u32 s31, s28, 8192
  buffer_load_dwordx4 v2, s[12:15], s31 offen offset:0 nt lds
  buffer_load_dwordx4 v3, s[12:15], s31 offen offset:1024 nt lds
  buffer_load_dwordx4 v2, s[12:15], s31 offen offset:2048 nt lds
  buffer_load_dwordx4 v3, s[12:15], s31 offen offset:3072 nt lds
  s_add_u32 m0, s26, 6144
  s_add_u32 s31, s29, 786432
  buffer_load_dwordx4 v4, s[16:19], s31 offen lds
  s_waitcnt vmcnt(22)
  s_add_u32 m0, s27, 12288
  s_add_u32 s31, s28, 12288
  buffer_load_dwordx4 v2, s[12:15], s31 offen offset:0 nt lds
  buffer_load_dwordx4 v3, s[12:15], s31 offen offset:1024 nt lds
  buffer_load_dwordx4 v2, s[12:15], s31 offen offset:2048 nt lds
  buffer_load_dwordx4 v3, s[12:15], s31 offen offset:3072 nt lds
  s_add_u32 m0, s26, 7168
  s_add_u32 s31, s29, 917504
  buffer_load_dwordx4 v5, s[16:19], s31 offen lds
  s_add_u32 s27, s27, 16384
  s_cmp_ge_u32 s27, 87808
  s_cselect_b32 s27, 5888, s27
  s_add_u32 s28, s28, 16384
  s_add_u32 s26, s26, 8192
  s_cmp_ge_u32 s26, 120576
  s_cselect_b32 s26, 87808, s26
  s_mov_b32 s28, s45
  s_add_u32 s33, s33, 1
  s_cmp_lt_u32 s33, 62
  s_cbranch_scc1 L_lloop
  s_add_u32 s44, s44, 1
  s_and_b32 s46, s44, 31
  s_lshl_b32 s29, s46, 7
  s_lshl_b32 s47, s21, 12
  s_add_u32 s29, s29, s47
  s_lshl_b32 s45, s46, 15
  s_lshl_b32 s47, s21, 20
  s_add_u32 s45, s45, s47
  s_mov_b32 s16, s10
  s_mov_b32 s17, s11
  s_cmp_lt_u32 s33, 5
  s_cbranch_scc1 L_fc8
  s_sub_u32 s37, s33, 4
  s_cmp_ge_u32 s36, s37
  s_cbranch_scc1 L_fc8
  s_mov_b32 s38, 0
L_fc7:
  ds_read_b32 v9, v7
  s_waitcnt lgkmcnt(0)
  v_readlane_b32 s40, v9, 0
  v_readlane_b32 s41, v9, 1
  v_readlane_b32 s42, v9, 2
  v_readlane_b32 s43, v9, 3
  s_min_u32 s40, s40, s41
  s_min_u32 s42, s42, s43
  s_min_u32 s36, s40, s42
  s_cmp_ge_u32 s36, s37
  s_cbranch_scc1 L_fc8
  s_add_u32 s38, s38, 1
  s_cmp_lt_u32 s38, 4194304
  s_cbranch_scc1 L_fc7
L_fc8:
  s_waitcnt vmcnt(22)
  s_add_u32 m0, s27, 0
  s_add_u32 s31, s28, 0
  buffer_load_dwordx4 v2, s[12:15], s31 offen offset:0 nt lds
  buffer_load_dwordx4 v3, s[12:15], s31 offen offset:1024 nt lds
  buffer_load_dwordx4 v2, s[12:15], s31 offen offset:2048 nt lds
  buffer_load_dwordx4 v3, s[12:15], s31 offen offset:3072 nt lds
  s_add_u32 m0, s26, 0
  s_add_u32 s31, s29, 0
  buffer_load_dwordx4 v4, s[16:19], s31 offen lds
  s_waitcnt vmcnt(22)
  s_cmp_lt_u32 s33, 2
  s_cbranch_scc1 L_ns9
  v_add_u32 v8, 1, v8
  ds_write_b32 v6, v8
L_ns9:
  s_add_u32 m0, s27, 4096
  s_add_u32 s31, s28, 4096
  buffer_load_dwordx4 v2, s[12:15], s31 offen offset:0 nt lds
  buffer_load_dwordx4 v3, s[12:15], s31 offen offset:1024 nt lds
  buffer_load_dwordx4 v2, s[12:15], s31 offen offset:2048 nt lds
  buffer_load_dwordx4 v3, s[12:15], s31 offen offset:3072 nt lds
  s_add_u32 m0, s26, 1024
  s_add_u32 s31, s29, 131072
  buffer_load_dwordx4 v5, s[16:19], s31 offen lds
  s_waitcnt vmcnt(22)
  s_add_u32 m0, s27, 8192
  s_add_u32 s31, s28, 8192
  buffer_load_dwordx4 v2, s[12:15], s31 offen offset:0 nt lds
  buffer_load_dwordx4 v3, s[12:15], s31 offen offset:1024 nt lds
  buffer_load_dwordx4 v2, s[12:15], s31 offen offset:2048 nt lds
  buffer_load_dwordx4 v3, s[12:15], s31 offen offset:3072 nt lds
  s_add_u32 m0, s26, 2048
  s_add_u32 s31, s29, 262144
  buffer_load_dwordx4 v4, s[16:19], s31 offen lds
  s_waitcnt vmcnt(22)
  s_add_u32 m0, s27, 12288
  s_add_u32 s31, s28, 12288
  buffer_load_dwordx4 v2, s[12:15], s31 offen offset:0 nt lds
  buffer_load_dwordx4 v3, s[12:15], s31 offen offset:1024 nt lds
  buffer_load_dwordx4 v2, s[12:15], s31 offen offset:2048 nt lds
  buffer_load_dwordx4 v3, s[12:15], s31 offen offset:3072 nt lds
  s_add_u32 m0, s26, 3072
  s_add_u32 s31, s29, 393216
  buffer_load_dwordx4 v5, s[16:19], s31 offen lds
  s_add_u32 s27, s27, 16384
  s_cmp_ge_u32 s27, 87808
  s_cselect_b32 s27, 5888, s27
  s_add_u32 s28, s28, 16384
  s_add_u32 s33, s33, 1
  s_cmp_lt_u32 s33, 5
  s_cbranch_scc1 L_fc11
  s_sub_u32 s37, s33, 4
  s_cmp_ge_u32 s36, s37
  s_cbranch_scc1 L_fc11
  s_mov_b32 s38, 0
L_fc10:
  ds_read_b32 v9, v7
  s_waitcnt lgkmcnt(0)
  v_readlane_b32 s40, v9, 0
  v_readlane_b32 s41, v9, 1
  v_readlane_b32 s42, v9, 2
  v_readlane_b32 s43, v9, 3
  s_min_u32 s40, s40, s41
  s_min_u32 s42, s42, s43
  s_min_u32 s36, s40, s42
  s_cmp_ge_u32 s36, s37
  s_cbranch_scc1 L_fc11
  s_add_u32 s38, s38, 1
  s_cmp_lt_u32 s38, 4194304
  s_cbranch_scc1 L_fc10
L_fc11:
  s_waitcnt vmcnt(22)
  s_add_u32 m0, s27, 0
  s_add_u32 s31, s28, 0
  buffer_load_dwordx4 v2, s[12:15], s31 offen offset:0 nt lds
  buffer_load_dwordx4 v3, s[12:15], s31 offen offset:1024 nt lds
  buffer_load_dwordx4 v2, s[12:15], s31 offen offset:2048 nt lds
  buffer_load_dwordx4 v3, s[12:15], s31 offen offset:3072 nt lds
  s_add_u32 m0, s26, 4096
  s_add_u32 s31, s29, 524288
  buffer_load_dwordx4 v4, s[16:19], s31 offen lds
  s_waitcnt vmcnt(22)
  s_cmp_lt_u32 s33, 2
  s_cbranch_scc1 L_ns12
  v_add_u32 v8, 1, v8
  ds_write_b32 v6, v8
L_ns12:
  s_add_u32 m0, s27, 4096
  s_add_u32 s31, s28, 4096
  buffer_load_dwordx4 v2, s[12:15], s31 offen offset:0 nt lds
  buffer_load_dwordx4 v3, s[12:15], s31 offen offset:1024 nt lds
  buffer_load_dwordx4 v2, s[12:15], s31 offen offset:2048 nt lds
  buffer_load_dwordx4 v3, s[12:15], s31 offen offset:3072 nt lds
  s_add_u32 m0, s26, 5120
  s_add_u32 s31, s29, 655360
  buffer_load_dwordx4 v5, s[16:19], s31 offen lds
  s_waitcnt vmcnt(22)
  s_add_u32 m0, s27, 8192
  s_add_u32 s31, s28, 8192
  buffer_load_dwordx4 v2, s[12:15], s31 offen offset:0 nt lds
  buffer_load_dwordx4 v3, s[12:15], s31 offen offset:1024 nt lds
  buffer_load_dwordx4 v2, s[12:15], s31 offen offset:2048 nt lds
  buffer_load_dwordx4 v3, s[12:15], s31 offen offset:3072 nt lds
  s_add_u32 m0, s26, 6144
  s_add_u32 s31, s29, 786432
  buffer_load_dwordx4 v4, s[16:19], s31 offen lds
  s_waitcnt vmcnt(22)
  s_add_u32 m0, s27, 12288
  s_add_u32 s31, s28, 12288
  buffer_load_dwordx4 v2, s[12:15], s31 offen offset:0 nt lds
  buffer_load_dwordx4 v3, s[12:15], s31 offen offset:1024 nt lds
  buffer_load_dwordx4 v2, s[12:15], s31 offen offset:2048 nt lds
  buffer_load_dwordx4 v3, s[12:15], s31 offen offset:3072 nt lds
  s_add_u32 m0, s26, 7168
  s_add_u32 s31, s29, 917504
  buffer_load_dwordx4 v5, s[16:19], s31 offen lds
  s_add_u32 s27, s27, 16384
  s_cmp_ge_u32 s27, 87808
  s_cselect_b32 s27, 5888, s27
  s_add_u32 s28, s28, 16384
  s_add_u32 s26, s26, 8192
  s_cmp_ge_u32 s26, 120576
  s_cselect_b32 s26, 87808, s26
  s_mov_b32 s28, s45
  s_add_u32 s33, s33, 1
  s_add_u32 s12, s6, s23
  s_addc_u32 s13, s7, 0
  s_mov_b32 s48, 0
  s_mov_b32 s49, 0
  s_mov_b32 s50, 0
  s_mov_b32 s51, 0
  v_mov_b32 v10, 5632
  v_lshl_add_u32 v10, v1, 2, v10
  v_mov_b32 v11, 5376
L_lloopva:
  s_add_u32 s48, s48, 1
  v_mov_b32 v12, s48
  ds_write_b32 v10, v12
  s_add_u32 s44, s44, 1
  s_and_b32 s46, s44, 31
  s_lshl_b32 s29, s46, 7
  s_lshl_b32 s47, s21, 12
  s_add_u32 s29, s29, s47
  s_lshl_b32 s45, s46, 15
  s_lshl_b32 s47, s21, 20
  s_add_u32 s45, s45, s47
  s_cmp_lt_u32 s33, 5
  s_cbranch_scc1 L_fc14
  s_sub_u32 s37, s33, 4
  s_cmp_ge_u32 s36, s37
  s_cbranch_scc1 L_fc14
  s_mov_b32 s38, 0
L_fc13:
  ds_read_b32 v9, v7
  s_waitcnt lgkmcnt(0)
  v_readlane_b32 s40, v9, 0
  v_readlane_b32 s41, v9, 1
  v_readlane_b32 s42, v9, 2
  v_readlane_b32 s43, v9, 3
  s_min_u32 s40, s40, s41
  s_min_u32 s42, s42, s43
  s_min_u32 s36, s40, s42
  s_cmp_ge_u32 s36, s37
  s_cbranch_scc1 L_fc14
  s_add_u32 s38, s38, 1
  s_cmp_lt_u32 s38, 4194304
  s_cbranch_scc1 L_fc13
L_fc14:
  s_waitcnt vmcnt(22)
  s_add_u32 m0, s27, 0
  s_add_u32 s31, s28, 0
  buffer_load_dwordx4 v2, s[12:15], s31 offen offset:0 nt lds
  buffer_load_dwordx4 v3, s[12:15], s31 offen offset:1024 nt lds
  buffer_load_dwordx4 v2, s[12:15], s31 offen offset:2048 nt lds
  buffer_load_dwordx4 v3, s[12:15], s31 offen offset:3072 nt lds
  s_add_u32 m0, s26, 0
  s_add_u32 s31, s29, 0
  buffer_load_dwordx4 v4, s[16:19], s31 offen lds
  s_waitcnt vmcnt(22)
  s_cmp_lt_u32 s33, 2
  s_cbranch_scc1 L_ns15
  v_add_u32 v8, 1, v8
  ds_write_b32 v6, v8
L_ns15:
  s_add_u32 m0, s27, 4096
  s_add_u32 s31, s28, 4096
  buffer_load_dwordx4 v2, s[12:15], s31 offen offset:0 nt lds
  buffer_load_dwordx4 v3, s[12:15], s31 offen offset:1024 nt lds
  buffer_load_dwordx4 v2, s[12:15], s31 offen offset:2048 nt lds
  buffer_load_dwordx4 v3, s[12:15], s31 offen offset:3072 nt lds
  s_add_u32 m0, s26, 1024
  s_add_u32 s31, s29, 131072
  buffer_load_dwordx4 v5, s[16:19], s31 offen lds
  s_waitcnt vmcnt(22)
  s_add_u32 m0, s27, 8192
  s_add_u32 s31, s28, 8192
  buffer_load_dwordx4 v2, s[12:15], s31 offen offset:0 nt lds
  buffer_load_dwordx4 v3, s[12:15], s31 offen offset:1024 nt lds
  buffer_load_dwordx4 v2, s[12:15], s31 offen offset:2048 nt lds
  buffer_load_dwordx4 v3, s[12:15], s31 offen offset:3072 nt lds
  s_add_u32 m0, s26, 2048
  s_add_u32 s31, s29, 262144
  buffer_load_dwordx4 v4, s[16:19], s31 offen lds
  s_waitcnt vmcnt(22)
  s_add_u32 m0, s27, 12288
  s_add_u32 s31, s28, 12288
  buffer_load_dwordx4 v2, s[12:15], s31 offen offset:0 nt lds
  buffer_load_dwordx4 v3, s[12:15], s31 offen offset:1024 nt lds
  buffer_load_dwordx4 v2, s[12:15], s31 offen offset:2048 nt lds
  buffer_load_dwordx4 v3, s[12:15], s31 offen offset:3072 nt lds
  s_add_u32 m0, s26, 3072
  s_add_u32 s31, s29, 393216
  buffer_load_dwordx4 v5, s[16:19], s31 offen lds
  s_add_u32 s27, s27, 16384
  s_cmp_ge_u32 s27, 87808
  s_cselect_b32 s27, 5888, s27
  s_add_u32 s28, s28, 16384
  s_add_u32 s33, s33, 1
  s_cmp_lt_u32 s33, 5
  s_cbranch_scc1 L_fc17
  s_sub_u32 s37, s33, 4
  s_cmp_ge_u32 s36, s37
  s_cbranch_scc1 L_fc17
  s_mov_b32 s38, 0
L_fc16:
  ds_read_b32 v9, v7
  s_waitcnt lgkmcnt(0)
  v_readlane_b32 s40, v9, 0
  v_readlane_b32 s41, v9, 1
  v_readlane_b32 s42, v9, 2
  v_readlane_b32 s43, v9, 3
  s_min_u32 s40, s40, s41
  s_min_u32 s42, s42, s43
  s_min_u32 s36, s40, s42
  s_cmp_ge_u32 s36, s37
  s_cbranch_scc1 L_fc17
  s_add_u32 s38, s38, 1
  s_cmp_lt_u32 s38, 4194304
  s_cbranch_scc1 L_fc16
L_fc17:
  s_waitcnt vmcnt(22)
  s_add_u32 m0, s27, 0
  s_add_u32 s31, s28, 0
  buffer_load_dwordx4 v2, s[12:15], s31 offen offset:0 nt lds
  buffer_load_dwordx4 v3, s[12:15], s31 offen offset:1024 nt lds
  buffer_load_dwordx4 v2, s[12:15], s31 offen offset:2048 nt lds
  buffer_load_dwordx4 v3, s[12:15], s31 offen offset:3072 nt lds
  s_add_u32 m0, s26, 4096
  s_add_u32 s31, s29, 524288
  buffer_load_dwordx4 v4, s[16:19], s31 offen lds
  s_waitcnt vmcnt(22)
  s_cmp_lt_u32 s33, 2
  s_cbranch_scc1 L_ns18
  v_add_u32 v8, 1, v8
  ds_write_b32 v6, v8
L_ns18:
  s_add_u32 m0, s27, 4096
  s_add_u32 s31, s28, 4096
  buffer_load_dwordx4 v2, s[12:15], s31 offen offset:0 nt lds
  buffer_load_dwordx4 v3, s[12:15], s31 offen offset:1024 nt lds
  buffer_load_dwordx4 v2, s[12:15], s31 offen offset:2048 nt lds
  buffer_load_dwordx4 v3, s[12:15], s31 offen offset:3072 nt lds
  s_add_u32 m0, s26, 5120
  s_add_u32 s31, s29, 655360
  buffer_load_dwordx4 v5, s[16:19], s31 offen lds
  s_waitcnt vmcnt(22)
  s_add_u32 m0, s27, 8192
  s_add_u32 s31, s28, 8192
  buffer_load_dwordx4 v2, s[12:15], s31 offen offset:0 nt lds
  buffer_load_dwordx4 v3, s[12:15], s31 offen offset:1024 nt lds
  buffer_load_dwordx4 v2, s[12:15], s31 offen offset:2048 nt lds
  buffer_load_dwordx4 v3, s[12:15], s31 offen offset:3072 nt lds
  s_add_u32 m0, s26, 6144
  s_add_u32 s31, s29, 786432
  buffer_load_dwordx4 v4, s[16:19], s31 offen lds
  s_waitcnt vmcnt(22)
  s_add_u32 m0, s27, 12288
  s_add_u32 s31, s28, 12288
  buffer_load_dwordx4 v2, s[12:15], s31 offen offset:0 nt lds
  buffer_load_dwordx4 v3, s[12:15], s31 offen offset:1024 nt lds
  buffer_load_dwordx4 v2, s[12:15], s31 offen offset:2048 nt lds
  buffer_load_dwordx4 v3, s[12:15], s31 offen offset:3072 nt lds
  s_add_u32 m0, s26, 7168
  s_add_u32 s31, s29, 917504
  buffer_load_dwordx4 v5, s[16:19], s31 offen lds
  s_add_u32 s27, s27, 16384
  s_cmp_ge_u32 s27, 87808
  s_cselect_b32 s27, 5888, s27
  s_add_u32 s28, s28, 16384
  s_add_u32 s26, s26, 8192
  s_cmp_ge_u32 s26, 120576
  s_cselect_b32 s26, 87808, s26
  s_mov_b32 s28, s45
  s_add_u32 s33, s33, 1
  s_cmp_lt_u32 s48, 28
  s_cbranch_scc1 L_lloopva
  s_mov_b32 s54, 1
L_lloopvb:
  s_add_u32 s48, s48, 1
  v_mov_b32 v12, s48
  ds_write_b32 v10, v12
  s_cmp_ge_u32 s48, 30
  s_cbranch_scc1 L_ldynb
  s_add_u32 s44, s44, 1
  s_and_b32 s46, s44, 31
  s_lshl_b32 s29, s46, 7
  s_lshl_b32 s47, s21, 12
  s_add_u32 s29, s29, s47
  s_lshl_b32 s45, s46, 15
  s_lshl_b32 s47, s21, 20
  s_add_u32 s45, s45, s47
  s_branch L_lgob
L_ldynb:
  s_mov_b32 s38, 0
L_lub:
  ds_read_b32 v13, v11
  s_waitcnt lgkmcnt(0)
  v_readfirstlane_b32 s40, v13
  s_add_u32 s38, s38, 1
  s_cmp_lg_u32 s40, 0
  s_cbranch_scc1 L_lu1b
  s_cmp_lt_u32 s38, 4194304
  s_cbranch_scc1 L_lub
  s_mov_b32 s40, 0x1000
L_lu1b:
  v_add_u32 v11, 4, v11
  s_cmp_ge_u32 s40, 0x1000
  s_cbranch_scc1 L_lendb
  s_sub_u32 s40, s40, 1
  s_lshr_b32 s41, s40, 5
  s_and_b32 s42, s40, 31
  s_add_u32 s42, s42, s34
  s_and_b32 s46, s42, 31
  s_lshl_b32 s29, s46, 7
  s_lshl_b32 s47, s41, 12
  s_add_u32 s29, s29, s47
  s_lshl_b32 s45, s46, 15
  s_lshl_b32 s47, s41, 20
  s_add_u32 s45, s45, s47
  s_branch L_lgob
L_lendb:
  s_mov_b32 s49, 1
  s_mov_b32 s18, 0
  s_add_u32 s40, s33, 2
  v_mov_b32 v12, s40
  v_add_u32 v13, 256, v6
  ds_write_b32 v13, v12
L_lgob:
  s_cmp_lt_u32 s33, 5
  s_cbranch_scc1 L_fc20
  s_sub_u32 s37, s33, 4
  s_cmp_ge_u32 s36, s37
  s_cbranch_scc1 L_fc20
  s_mov_b32 s38, 0
L_fc19:
  ds_read_b32 v9, v7
  s_waitcnt lgkmcnt(0)
  v_readlane_b32 s40, v9, 0
  v_readlane_b32 s41, v9, 1
  v_readlane_b32 s42, v9, 2
  v_readlane_b32 s43, v9, 3
  s_min_u32 s40, s40, s41
  s_min_u32 s42, s42, s43
  s_min_u32 s36, s40, s42
  s_cmp_ge_u32 s36, s37
  s_cbranch_scc1 L_fc20
  s_add_u32 s38, s38, 1
  s_cmp_lt_u32 s38, 4194304
  s_cbranch_scc1 L_fc19
L_fc20:
  s_waitcnt vmcnt(40)
  s_cmp_eq_u32 s54, 0
  s_cbranch_scc1 L_sk22
  s_mov_b32 s54, 0
  s_branch L_ns21
L_sk22:
  v_add_u32 v8, 1, v8
  ds_write_b32 v6, v8
L_ns21:
  s_add_u32 m0, s27, 0
  s_add_u32 s31, s28, 0
  buffer_load_dwordx4 v2, s[12:15], s31 offen offset:0 nt lds
  buffer_load_dwordx4 v3, s[12:15], s31 offen offset:1024 nt lds
  buffer_load_dwordx4 v2, s[12:15], s31 offen offset:2048 nt lds
  buffer_load_dwordx4 v3, s[12:15], s31 offen offset:3072 nt lds
  s_add_u32 m0, s26, 0
  s_add_u32 s31, s29, 0
  buffer_load_dwordx4 v4, s[16:19], s31 offen lds
  s_waitcnt vmcnt(40)
  s_add_u32 m0, s27, 4096
  s_add_u32 s31, s28, 4096
  buffer_load_dwordx4 v2, s[12:15], s31 offen offset:0 nt lds
  buffer_load_dwordx4 v3, s[12:15], s31 offen offset:1024 nt lds
  buffer_load_dwordx4 v2, s[12:15], s31 offen offset:2048 nt lds
  buffer_load_dwordx4 v3, s[12:15], s31 offen offset:3072 nt lds
  s_add_u32 m0, s26, 1024
  s_add_u32 s31, s29, 131072
  buffer_load_dwordx4 v5, s[16:19], s31 offen lds
  s_waitcnt vmcnt(40)
  s_add_u32 m0, s27, 8192
  s_add_u32 s31, s28, 8192
  buffer_load_dwordx4 v2, s[12:15], s31 offen offset:0 nt lds
  buffer_load_dwordx4 v3, s[12:15], s31 offen offset:1024 nt lds
  buffer_load_dwordx4 v2, s[12:15], s31 offen offset:2048 nt lds
  buffer_load_dwordx4 v3, s[12:15], s31 offen offset:3072 nt lds
  s_add_u32 m0, s26, 2048
  s_add_u32 s31, s29, 262144
  buffer_load_dwordx4 v4, s[16:19], s31 offen lds
  s_waitcnt vmcnt(40)
  s_add_u32 m0, s27, 12288
  s_add_u32 s31, s28, 12288
  buffer_load_dwordx4 v2, s[12:15], s31 offen offset:0 nt lds
  buffer_load_dwordx4 v3, s[12:15], s31 offen offset:1024 nt lds
  buffer_load_dwordx4 v2, s[12:15], s31 offen offset:2048 nt lds
  buffer_load_dwordx4 v3, s[12:15], s31 offen offset:3072 nt lds
  s_add_u32 m0, s26, 3072
  s_add_u32 s31, s29, 393216
  buffer_load_dwordx4 v5, s[16:19], s31 offen lds
  s_add_u32 s27, s27, 16384
  s_cmp_ge_u32 s27, 87808
  s_cselect_b32 s27, 5888, s27
  s_add_u32 s28, s28, 16384
  s_add_u32 s33, s33, 1
  s_cmp_lt_u32 s33, 5
  s_cbranch_scc1 L_fc24
  s_sub_u32 s37, s33, 4
  s_cmp_ge_u32 s36, s37
  s_cbranch_scc1 L_fc24
  s_mov_b32 s38, 0
L_fc23:
  ds_read_b32 v9, v7
  s_waitcnt lgkmcnt(0)
  v_readlane_b32 s40, v9, 0
  v_readlane_b32 s41, v9, 1
  v_readlane_b32 s42, v9, 2
  v_readlane_b32 s43, v9, 3
  s_min_u32 s40, s40, s41
  s_min_u32 s42, s42, s43
  s_min_u32 s36, s40, s42
  s_cmp_ge_u32 s36, s37
  s_cbranch_scc1 L_fc24
  s_add_u32 s38, s38, 1
  s_cmp_lt_u32 s38, 4194304
  s_cbranch_scc1 L_fc23
L_fc24:
  s_waitcnt vmcnt(40)
  s_cmp_eq_u32 s54, 0
  s_cbranch_scc1 L_sk26
  s_mov_b32 s54, 0
  s_branch L_ns25
L_sk26:
  v_add_u32 v8, 1, v8
  ds_write_b32 v6, v8
L_ns25:
  s_add_u32 m0, s27, 0
  s_add_u32 s31, s28, 0
  buffer_load_dwordx4 v2, s[12:15], s31 offen offset:0 nt lds
  buffer_load_dwordx4 v3, s[12:15], s31 offen offset:1024 nt lds
  buffer_load_dwordx4 v2, s[12:15], s31 offen offset:2048 nt lds
  buffer_load_dwordx4 v3, s[12:15], s31 offen offset:3072 nt lds
  s_add_u32 m0, s26, 4096
  s_add_u32 s31, s29, 524288
  buffer_load_dwordx4 v4, s[16:19], s31 offen lds
  s_waitcnt vmcnt(40)
  s_add_u32 m0, s27, 4096
  s_add_u32 s31, s28, 4096
  buffer_load_dwordx4 v2, s[12:15], s31 offen offset:0 nt lds
  buffer_load_dwordx4 v3, s[12:15], s31 offen offset:1024 nt lds
  buffer_load_dwordx4 v2, s[12:15], s31 offen offset:2048 nt lds
  buffer_load_dwordx4 v3, s[12:15], s31 offen offset:3072 nt lds
  s_add_u32 m0, s26, 5120
  s_add_u32 s31, s29, 655360
  buffer_load_dwordx4 v5, s[16:19], s31 offen lds
  s_waitcnt vmcnt(40)
  s_add_u32 m0, s27, 8192
  s_add_u32 s31, s28, 8192
  buffer_load_dwordx4 v2, s[12:15], s31 offen offset:0 nt lds
  buffer_load_dwordx4 v3, s[12:15], s31 offen offset:1024 nt lds
  buffer_load_dwordx4 v2, s[12:15], s31 offen offset:2048 nt lds
  buffer_load_dwordx4 v3, s[12:15], s31 offen offset:3072 nt lds
  s_add_u32 m0, s26, 6144
  s_add_u32 s31, s29, 786432
  buffer_load_dwordx4 v4, s[16:19], s31 offen lds
  s_waitcnt vmcnt(40)
  s_add_u32 m0, s27, 12288
  s_add_u32 s31, s28, 12288
  buffer_load_dwordx4 v2, s[12:15], s31 offen offset:0 nt lds
  buffer_load_dwordx4 v3, s[12:15], s31 offen offset:1024 nt lds
  buffer_load_dwordx4 v2, s[12:15], s31 offen offset:2048 nt lds
  buffer_load_dwordx4 v3, s[12:15], s31 offen offset:3072 nt lds
  s_add_u32 m0, s26, 7168
  s_add_u32 s31, s29, 917504
  buffer_load_dwordx4 v5, s[16:19], s31 offen lds
  s_add_u32 s27, s27, 16384
  s_cmp_ge_u32 s27, 87808
  s_cselect_b32 s27, 5888, s27
  s_add_u32 s28, s28, 16384
  s_add_u32 s26, s26, 8192
  s_cmp_ge_u32 s26, 120576
  s_cselect_b32 s26, 87808, s26
  s_mov_b32 s28, s45
  s_add_u32 s33, s33, 1
  s_cmp_eq_u32 s49, 0
  s_cbranch_scc1 L_lloopvb
  s_waitcnt vmcnt(40)
  v_add_u32 v8, 1, v8
  ds_write_b32 v6, v8
  s_waitcnt vmcnt(20)
  v_add_u32 v8, 1, v8
  ds_write_b32 v6, v8
  s_waitcnt vmcnt(0)
  v_add_u32 v8, 1, v8
  ds_write_b32 v6, v8
  s_waitcnt lgkmcnt(0)
  s_endpgm
L_consumer:
  s_cmp_lg_u32 s3, 0
  s_cbranch_scc1 L_cnz
  v_mov_b32 v16, 0
  v_mov_b32 v17, 0
  v_mov_b32 v18, 0
  v_mov_b32 v19, 0
  v_lshlrev_b32 v10, 4, v1
  ds_write_b128 v10, v[16:19] offset:2304
  ds_write_b128 v10, v[16:19] offset:3328
  ds_write_b128 v10, v[16:19] offset:4352
  v_cmp_gt_u32 vcc, 32, v1
  s_and_saveexec_b64 s[40:41], vcc
  ds_write_b128 v10, v[16:19] offset:5376
  s_mov_b64 exec, s[40:41]
  s_waitcnt lgkmcnt(0)
L_cnz:
  v_lshrrev_b32 v10, 5, v1
  v_bfe_u32 v11, v1, 2, 2
  v_lshl_add_u32 v12, v10, 3, v11
  v_lshlrev_b32 v12, 9, v12
  s_lshl_b32 s22, s3, 1
  v_xor_b32 v13, s22, v11
  v_lshlrev_b32 v13, 6, v13
  v_bfe_u32 v14, v1, 4, 1
  v_lshlrev_b32 v14, 5, v14
  v_and_b32 v15, 3, v1
  v_lshlrev_b32 v15, 3, v15
  v_add3_u32 v5, v12, v13, v14
  v_add_u32 v5, v5, v15
  v_xor_b32 v6, 64, v5
  v_and_b32 v11, 31, v1
  v_bfe_u32 v12, v1, 1, 3
  v_xor_b32 v12, v12, v10
  v_lshlrev_b32 v12, 4, v12
  v_lshl_add_u32 v7, v11, 7, v12
  v_xor_b32 v8, 32, v7
  v_lshlrev_b32 v9, 4, v10
  s_lshl_b32 s22, s3, 8
  s_add_u32 s22, s22, 2816
  v_lshl_add_u32 v3, v1, 2, s22
  v_mov_b32 v2, 2304
  v_mov_b32 v4, 0
  v_mov_b32 v48, 0
  v_mov_b32 v49, 0
  v_mov_b32 v50, 0
  v_mov_b32 v51, 0
  v_mov_b32 v52, 0
  v_mov_b32 v53, 0
  v_mov_b32 v54, 0
  v_mov_b32 v55, 0
  v_mov_b32 v56, 0
  v_mov_b32 v57, 0
  v_mov_b32 v58, 0
  v_mov_b32 v59, 0
  v_mov_b32 v60, 0
  v_mov_b32 v61, 0
  v_mov_b32 v62, 0
  v_mov_b32 v63, 0
  v_mov_b32 v64, 0
  v_mov_b32 v65, 0
  v_mov_b32 v66, 0
  v_mov_b32 v67, 0
  v_mov_b32 v68, 0
  v_mov_b32 v69, 0
  v_mov_b32 v70, 0
  v_mov_b32 v71, 0
  v_mov_b32 v72, 0
  v_mov_b32 v73, 0
  v_mov_b32 v74, 0
  v_mov_b32 v75, 0
  v_mov_b32 v76, 0
  v_mov_b32 v77, 0
  v_mov_b32 v78, 0
  v_mov_b32 v79, 0
  v_mov_b32 v80, 0
  v_mov_b32 v81, 0
  v_mov_b32 v82, 0
  v_mov_b32 v83, 0
  v_mov_b32 v84, 0
  v_mov_b32 v85, 0
  v_mov_b32 v86, 0
  v_mov_b32 v87, 0
  v_mov_b32 v88, 0
  v_mov_b32 v89, 0
  v_mov_b32 v90, 0
  v_mov_b32 v91, 0
  v_mov_b32 v92, 0
  v_mov_b32 v93, 0
  v_mov_b32 v94, 0
  v_mov_b32 v95, 0
  v_mov_b32 v96, 0
  v_mov_b32 v97, 0
  v_mov_b32 v98, 0
  v_mov_b32 v99, 0
  v_mov_b32 v100, 0
  v_mov_b32 v101, 0
  v_mov_b32 v102, 0
  v_mov_b32 v103, 0
  v_mov_b32 v104, 0
  v_mov_b32 v105, 0
  v_mov_b32 v106, 0
  v_mov_b32 v107, 0
  v_mov_b32 v108, 0
  v_mov_b32 v109, 0
  v_mov_b32 v110, 0
  v_mov_b32 v111, 0
  s_mov_b32 s31, 5888
  s_mov_b32 s30, 87808
  s_mov_b32 s33, 0
  s_mov_b32 s35, 0
  s_mov_b32 s34, 0
  s_barrier
L_kloop:
  v_add_u32 v10, s31, v5
  v_add_u32 v11, s31, v6
  v_add_u32 v12, s30, v7
  v_add_u32 v13, s30, v8
  s_cmp_gt_u32 s35, s33
  s_cbranch_scc1 L_lw27
  s_mov_b32 s38, 0
L_sp28:
  ds_read2_b32 v[14:15], v2 offset0:0 offset1:64
  s_waitcnt lgkmcnt(0)
  v_readfirstlane_b32 s35, v14
  v_readfirstlane_b32 s34, v15
  s_add_u32 s38, s38, 1
  s_cmp_gt_u32 s35, s33
  s_cbranch_scc1 L_sp29
  s_cmp_lt_u32 s38, 4194304
  s_cbranch_scc1 L_sp28
L_sp29:
L_lw27:
  ds_read_b128 v[16:19], v12 offset:0
  ds_read_b128 v[24:27], v12 offset:4096
  ds_read_b64_tr_b16 v[32:33], v10 offset:0
  ds_read_b64_tr_b16 v[34:35], v10 offset:2048
  ds_read_b64_tr_b16 v[40:41], v11 offset:0
  ds_read_b64_tr_b16 v[42:43], v11 offset:2048
  ds_read_b128 v[20:23], v13 offset:0
  ds_read_b128 v[28:31], v13 offset:4096
  ds_read_b64_tr_b16 v[36:37], v10 offset:8192
  ds_read_b64_tr_b16 v[38:39], v10 offset:10240
  ds_read_b64_tr_b16 v[44:45], v11 offset:8192
  ds_read_b64_tr_b16 v[46:47], v11 offset:10240
  v_add_u32 v4, 1, v4
  v_xor_b32 v7, 64, v7
  v_xor_b32 v8, 64, v8
  s_add_u32 s31, s31, 16384
  s_cmp_ge_u32 s31, 87808
  s_cselect_b32 s31, 5888, s31
  s_bitcmp1_b32 s33, 0
  s_cselect_b32 s32, 8192, 0
  s_add_u32 s30, s30, s32
  s_cmp_ge_u32 s30, 120576
  s_cselect_b32 s30, 87808, s30
  s_waitcnt lgkmcnt(6)
  v_mfma_f32_32x32x16_bf16 v[48:63], v[32:35], v[16:19], v[48:63]
  v_mfma_f32_32x32x16_bf16 v[64:79], v[32:35], v[24:27], v[64:79]
  v_mfma_f32_32x32x16_bf16 v[80:95], v[40:43], v[16:19], v[80:95]
  v_mfma_f32_32x32x16_bf16 v[96:111], v[40:43], v[24:27], v[96:111]
  s_waitcnt lgkmcnt(0)
  ds_write_b32 v3, v4
  v_mfma_f32_32x32x16_bf16 v[48:63], v[36:39], v[20:23], v[48:63]
  v_mfma_f32_32x32x16_bf16 v[64:79], v[36:39], v[28:31], v[64:79]
  v_mfma_f32_32x32x16_bf16 v[80:95], v[44:47], v[20:23], v[80:95]
  v_mfma_f32_32x32x16_bf16 v[96:111], v[44:47], v[28:31], v[96:111]
  s_add_u32 s33, s33, 1
  s_cmp_lt_u32 s33, 64
  s_cbranch_scc1 L_kloop
  v_mov_b32 v20, 4864
  s_mov_b32 s38, 0
L_sp30:
  ds_read_b32 v14, v20 offset:0
  s_waitcnt lgkmcnt(0)
  v_readfirstlane_b32 s39, v14
  s_add_u32 s38, s38, 1
  s_cmp_lg_u32 s39, 0
  s_cbranch_scc1 L_sp31
  s_cmp_lt_u32 s38, 4194304
  s_cbranch_scc1 L_sp30
L_sp31:
  s_lshl_b32 s22, s3, 8
  s_add_u32 s22, s22, 0
  v_add_u32 v10, s22, v9
  ds_read_b128 v[112:115], v10 offset:0
  ds_read_b128 v[116:119], v10 offset:32
  ds_read_b128 v[120:123], v10 offset:64
  ds_read_b128 v[124:127], v10 offset:96
  ds_read_b128 v[128:131], v10 offset:128
  ds_read_b128 v[132:135], v10 offset:160
  ds_read_b128 v[136:139], v10 offset:192
  ds_read_b128 v[140:143], v10 offset:224
  s_nop 7
  s_waitcnt lgkmcnt(0)
  v_pk_mul_f32 v[16:17], v[112:113], v[48:49]
  v_pk_mul_f32 v[18:19], v[112:113], v[64:65]
  v_pk_fma_f32 v[16:17], v[114:115], v[50:51], v[16:17]
  v_pk_fma_f32 v[18:19], v[114:115], v[66:67], v[18:19]
  v_pk_fma_f32 v[16:17], v[116:117], v[52:53], v[16:17]
  v_pk_fma_f32 v[18:19], v[116:117], v[68:69], v[18:19]
  v_pk_fma_f32 v[16:17], v[118:119], v[54:55], v[16:17]
  v_pk_fma_f32 v[18:19], v[118:119], v[70:71], v[18:19]
  v_pk_fma_f32 v[16:17], v[120:121], v[56:57], v[16:17]
  v_pk_fma_f32 v[18:19], v[120:121], v[72:73], v[18:19]
  v_pk_fma_f32 v[16:17], v[122:123], v[58:59], v[16:17]
  v_pk_fma_f32 v[18:19], v[122:123], v[74:75], v[18:19]
  v_pk_fma_f32 v[16:17], v[124:125], v[60:61], v[16:17]
  v_pk_fma_f32 v[18:19], v[124:125], v[76:77], v[18:19]
  v_pk_fma_f32 v[16:17], v[126:127], v[62:63], v[16:17]
  v_pk_fma_f32 v[18:19], v[126:127], v[78:79], v[18:19]
  v_pk_fma_f32 v[16:17], v[128:129], v[80:81], v[16:17]
  v_pk_fma_f32 v[18:19], v[128:129], v[96:97], v[18:19]
  v_pk_fma_f32 v[16:17], v[130:131], v[82:83], v[16:17]
  v_pk_fma_f32 v[18:19], v[130:131], v[98:99], v[18:19]
  v_pk_fma_f32 v[16:17], v[132:133], v[84:85], v[16:17]
  v_pk_fma_f32 v[18:19], v[132:133], v[100:101], v[18:19]
  v_pk_fma_f32 v[16:17], v[134:135], v[86:87], v[16:17]
  v_pk_fma_f32 v[18:19], v[134:135], v[102:103], v[18:19]
  v_pk_fma_f32 v[16:17], v[136:137], v[88:89], v[16:17]
  v_pk_fma_f32 v[18:19], v[136:137], v[104:105], v[18:19]
  v_pk_fma_f32 v[16:17], v[138:139], v[90:91], v[16:17]
  v_pk_fma_f32 v[18:19], v[138:139], v[106:107], v[18:19]
  v_pk_fma_f32 v[16:17], v[140:141], v[92:93], v[16:17]
  v_pk_fma_f32 v[18:19], v[140:141], v[108:109], v[18:19]
  v_pk_fma_f32 v[16:17], v[142:143], v[94:95], v[16:17]
  v_pk_fma_f32 v[18:19], v[142:143], v[110:111], v[18:19]
  v_add_f32 v14, v16, v17
  v_add_f32 v15, v18, v19
  s_nop 1
  v_permlane32_swap_b32 v14, v15
  s_nop 1
  v_add_f32 v14, v14, v15
  s_lshl_b32 s22, s3, 8
  s_add_u32 s22, s22, 1024
  v_lshl_add_u32 v10, v1, 2, s22
  ds_write_b32 v10, v14
  v_add_u32 v10, 2816, v10
  v_mov_b32 v15, 1
  s_waitcnt lgkmcnt(0)
  ds_write_b32 v10, v15
  v_mov_b32 v48, 0
  v_mov_b32 v49, 0
  v_mov_b32 v50, 0
  v_mov_b32 v51, 0
  v_mov_b32 v52, 0
  v_mov_b32 v53, 0
  v_mov_b32 v54, 0
  v_mov_b32 v55, 0
  v_mov_b32 v56, 0
  v_mov_b32 v57, 0
  v_mov_b32 v58, 0
  v_mov_b32 v59, 0
  v_mov_b32 v60, 0
  v_mov_b32 v61, 0
  v_mov_b32 v62, 0
  v_mov_b32 v63, 0
  v_mov_b32 v64, 0
  v_mov_b32 v65, 0
  v_mov_b32 v66, 0
  v_mov_b32 v67, 0
  v_mov_b32 v68, 0
  v_mov_b32 v69, 0
  v_mov_b32 v70, 0
  v_mov_b32 v71, 0
  v_mov_b32 v72, 0
  v_mov_b32 v73, 0
  v_mov_b32 v74, 0
  v_mov_b32 v75, 0
  v_mov_b32 v76, 0
  v_mov_b32 v77, 0
  v_mov_b32 v78, 0
  v_mov_b32 v79, 0
  v_mov_b32 v80, 0
  v_mov_b32 v81, 0
  v_mov_b32 v82, 0
  v_mov_b32 v83, 0
  v_mov_b32 v84, 0
  v_mov_b32 v85, 0
  v_mov_b32 v86, 0
  v_mov_b32 v87, 0
  v_mov_b32 v88, 0
  v_mov_b32 v89, 0
  v_mov_b32 v90, 0
  v_mov_b32 v91, 0
  v_mov_b32 v92, 0
  v_mov_b32 v93, 0
  v_mov_b32 v94, 0
  v_mov_b32 v95, 0
  v_mov_b32 v96, 0
  v_mov_b32 v97, 0
  v_mov_b32 v98, 0
  v_mov_b32 v99, 0
  v_mov_b32 v100, 0
  v_mov_b32 v101, 0
  v_mov_b32 v102, 0
  v_mov_b32 v103, 0
  v_mov_b32 v104, 0
  v_mov_b32 v105, 0
  v_mov_b32 v106, 0
  v_mov_b32 v107, 0
  v_mov_b32 v108, 0
  v_mov_b32 v109, 0
  v_mov_b32 v110, 0
  v_mov_b32 v111, 0
L_vloop:
  v_add_u32 v10, s31, v5
  v_add_u32 v11, s31, v6
  v_add_u32 v12, s30, v7
  v_add_u32 v13, s30, v8
  s_cmp_gt_u32 s35, s33
  s_cbranch_scc1 L_lw32
  s_mov_b32 s38, 0
L_sp33:
  ds_read2_b32 v[14:15], v2 offset0:0 offset1:64
  s_waitcnt lgkmcnt(0)
  v_readfirstlane_b32 s35, v14
  v_readfirstlane_b32 s34, v15
  s_add_u32 s38, s38, 1
  s_cmp_gt_u32 s35, s33
  s_cbranch_scc1 L_sp34
  s_cmp_lt_u32 s38, 4194304
  s_cbranch_scc1 L_sp33
L_sp34:
L_lw32:
  ds_read_b128 v[16:19], v12 offset:0
  ds_read_b128 v[24:27], v12 offset:4096
  ds_read_b64_tr_b16 v[32:33], v10 offset:0
  ds_read_b64_tr_b16 v[34:35], v10 offset:2048
  ds_read_b64_tr_b16 v[40:41], v11 offset:0
  ds_read_b64_tr_b16 v[42:43], v11 offset:2048
  ds_read_b128 v[20:23], v13 offset:0
  ds_read_b128 v[28:31], v13 offset:4096
  ds_read_b64_tr_b16 v[36:37], v10 offset:8192
  ds_read_b64_tr_b16 v[38:39], v10 offset:10240
  ds_read_b64_tr_b16 v[44:45], v11 offset:8192
  ds_read_b64_tr_b16 v[46:47], v11 offset:10240
  v_add_u32 v4, 1, v4
  v_xor_b32 v7, 64, v7
  v_xor_b32 v8, 64, v8
  s_add_u32 s31, s31, 16384
  s_cmp_ge_u32 s31, 87808
  s_cselect_b32 s31, 5888, s31
  s_bitcmp1_b32 s33, 0
  s_cselect_b32 s32, 8192, 0
  s_add_u32 s30, s30, s32
  s_cmp_ge_u32 s30, 120576
  s_cselect_b32 s30, 87808, s30
  s_waitcnt lgkmcnt(6)
  v_mfma_f32_32x32x16_bf16 v[48:63], v[16:19], v[32:35], v[48:63]
  v_mfma_f32_32x32x16_bf16 v[64:79], v[16:19], v[40:43], v[64:79]
  v_mfma_f32_32x32x16_bf16 v[80:95], v[24:27], v[32:35], v[80:95]
  v_mfma_f32_32x32x16_bf16 v[96:111], v[24:27], v[40:43], v[96:111]
  s_waitcnt lgkmcnt(0)
  ds_write_b32 v3, v4
  v_mfma_f32_32x32x16_bf16 v[48:63], v[20:23], v[36:39], v[48:63]
  v_mfma_f32_32x32x16_bf16 v[64:79], v[20:23], v[44:47], v[64:79]
  v_mfma_f32_32x32x16_bf16 v[80:95], v[28:31], v[36:39], v[80:95]
  v_mfma_f32_32x32x16_bf16 v[96:111], v[28:31], v[44:47], v[96:111]
  s_add_u32 s33, s33, 1
  s_add_u32 s32, s33, 1
  s_cmp_eq_u32 s32, s34
  s_cbranch_scc1 L_vlast
  s_cmp_lt_u32 s33, 255
  s_cbranch_scc1 L_vloop
L_vlast:
  v_mov_b32 v20, 5120
  s_mov_b32 s38, 0
L_sp35:
  ds_read_b32 v14, v20 offset:0
  s_waitcnt lgkmcnt(0)
  v_readfirstlane_b32 s39, v14
  s_add_u32 s38, s38, 1
  s_cmp_lg_u32 s39, 0
  s_cbranch_scc1 L_sp36
  s_cmp_lt_u32 s38, 4194304
  s_cbranch_scc1 L_sp35
L_sp36:
  v_add_u32 v10, 2048, v9
  ds_read_b128 v[112:115], v10 offset:0
  ds_read_b128 v[116:119], v10 offset:32
  ds_read_b128 v[120:123], v10 offset:64
  ds_read_b128 v[124:127], v10 offset:96
  ds_read_b128 v[128:131], v10 offset:128
  ds_read_b128 v[132:135], v10 offset:160
  ds_read_b128 v[136:139], v10 offset:192
  ds_read_b128 v[140:143], v10 offset:224
  s_load_dwordx2 s[40:41], s[0:1], 40
  s_load_dwordx2 s[44:45], s[0:1], 56
  s_lshl_b32 s22, s20, 12
  s_add_u32 s22, s22, 65536
  s_lshl_b32 s48, s3, 8
  v_lshl_add_u32 v148, v1, 2, s48
  s_waitcnt lgkmcnt(0)
  s_add_u32 s44, s44, s22
  s_addc_u32 s45, s45, 0
  s_add_u32 s22, s21, 1
  s_and_b32 s22, s22, 3
  s_lshl_b32 s22, s22, 10
  v_add_u32 v149, s22, v148
  s_add_u32 s22, s21, 2
  s_and_b32 s22, s22, 3
  s_lshl_b32 s22, s22, 10
  v_add_u32 v150, s22, v148
  s_add_u32 s22, s21, 3
  s_and_b32 s22, s22, 3
  s_lshl_b32 s22, s22, 10
  v_add_u32 v151, s22, v148
  global_load_dword v144, v149, s[44:45] sc1
  global_load_dword v145, v150, s[44:45] sc1
  global_load_dword v146, v151, s[44:45] sc1
  v_add_u32 v10, s31, v5
  v_add_u32 v11, s31, v6
  v_add_u32 v12, s30, v7
  v_add_u32 v13, s30, v8
  s_cmp_gt_u32 s35, s33
  s_cbranch_scc1 L_lw37
  s_mov_b32 s38, 0
L_sp38:
  ds_read2_b32 v[14:15], v2 offset0:0 offset1:64
  s_waitcnt lgkmcnt(0)
  v_readfirstlane_b32 s35, v14
  v_readfirstlane_b32 s34, v15
  s_add_u32 s38, s38, 1
  s_cmp_gt_u32 s35, s33
  s_cbranch_scc1 L_sp39
  s_cmp_lt_u32 s38, 4194304
  s_cbranch_scc1 L_sp38
L_sp39:
L_lw37:
  ds_read_b128 v[16:19], v12 offset:0
  ds_read_b128 v[24:27], v12 offset:4096
  ds_read_b64_tr_b16 v[32:33], v10 offset:0
  ds_read_b64_tr_b16 v[34:35], v10 offset:2048
  ds_read_b64_tr_b16 v[40:41], v11 offset:0
  ds_read_b64_tr_b16 v[42:43], v11 offset:2048
  ds_read_b128 v[20:23], v13 offset:0
  ds_read_b128 v[28:31], v13 offset:4096
  ds_read_b64_tr_b16 v[36:37], v10 offset:8192
  ds_read_b64_tr_b16 v[38:39], v10 offset:10240
  ds_read_b64_tr_b16 v[44:45], v11 offset:8192
  ds_read_b64_tr_b16 v[46:47], v11 offset:10240
  v_add_u32 v4, 1, v4
  v_xor_b32 v7, 64, v7
  v_xor_b32 v8, 64, v8
  s_add_u32 s31, s31, 16384
  s_cmp_ge_u32 s31, 87808
  s_cselect_b32 s31, 5888, s31
  s_bitcmp1_b32 s33, 0
  s_cselect_b32 s32, 8192, 0
  s_add_u32 s30, s30, s32
  s_cmp_ge_u32 s30, 120576
  s_cselect_b32 s30, 87808, s30
  s_waitcnt lgkmcnt(6)
  v_mfma_f32_32x32x16_bf16 v[48:63], v[16:19], v[32:35], v[48:63]
  v_mfma_f32_32x32x16_bf16 v[64:79], v[16:19], v[40:43], v[64:79]
  v_mfma_f32_32x32x16_bf16 v[80:95], v[24:27], v[32:35], v[80:95]
  v_mfma_f32_32x32x16_bf16 v[96:111], v[24:27], v[40:43], v[96:111]
  s_waitcnt lgkmcnt(0)
  ds_write_b32 v3, v4
  v_mfma_f32_32x32x16_bf16 v[48:63], v[20:23], v[36:39], v[48:63]
  v_mfma_f32_32x32x16_bf16 v[64:79], v[20:23], v[44:47], v[64:79]
  v_mfma_f32_32x32x16_bf16 v[80:95], v[28:31], v[36:39], v[80:95]
  v_mfma_f32_32x32x16_bf16 v[96:111], v[28:31], v[44:47], v[96:111]
  s_nop 15
  v_pk_mul_f32 v[16:17], v[112:113], v[48:49]
  v_pk_mul_f32 v[18:19], v[112:113], v[64:65]
  v_pk_fma_f32 v[16:17], v[114:115], v[50:51], v[16:17]
  v_pk_fma_f32 v[18:19], v[114:115], v[66:67], v[18:19]
  v_pk_fma_f32 v[16:17], v[116:117], v[52:53], v[16:17]
  v_pk_fma_f32 v[18:19], v[116:117], v[68:69], v[18:19]
  v_pk_fma_f32 v[16:17], v[118:119], v[54:55], v[16:17]
  v_pk_fma_f32 v[18:19], v[118:119], v[70:71], v[18:19]
  v_pk_fma_f32 v[16:17], v[120:121], v[56:57], v[16:17]
  v_pk_fma_f32 v[18:19], v[120:121], v[72:73], v[18:19]
  v_pk_fma_f32 v[16:17], v[122:123], v[58:59], v[16:17]
  v_pk_fma_f32 v[18:19], v[122:123], v[74:75], v[18:19]
  v_pk_fma_f32 v[16:17], v[124:125], v[60:61], v[16:17]
  v_pk_fma_f32 v[18:19], v[124:125], v[76:77], v[18:19]
  v_pk_fma_f32 v[16:17], v[126:127], v[62:63], v[16:17]
  v_pk_fma_f32 v[18:19], v[126:127], v[78:79], v[18:19]
  v_pk_fma_f32 v[16:17], v[128:129], v[80:81], v[16:17]
  v_pk_fma_f32 v[18:19], v[128:129], v[96:97], v[18:19]
  v_pk_fma_f32 v[16:17], v[130:131], v[82:83], v[16:17]
  v_pk_fma_f32 v[18:19], v[130:131], v[98:99], v[18:19]
  v_pk_fma_f32 v[16:17], v[132:133], v[84:85], v[16:17]
  v_pk_fma_f32 v[18:19], v[132:133], v[100:101], v[18:19]
  v_pk_fma_f32 v[16:17], v[134:135], v[86:87], v[16:17]
  v_pk_fma_f32 v[18:19], v[134:135], v[102:103], v[18:19]
  v_pk_fma_f32 v[16:17], v[136:137], v[88:89], v[16:17]
  v_pk_fma_f32 v[18:19], v[136:137], v[104:105], v[18:19]
  v_pk_fma_f32 v[16:17], v[138:139], v[90:91], v[16:17]
  v_pk_fma_f32 v[18:19], v[138:139], v[106:107], v[18:19]
  v_pk_fma_f32 v[16:17], v[140:141], v[92:93], v[16:17]
  v_pk_fma_f32 v[18:19], v[140:141], v[108:109], v[18:19]
  v_pk_fma_f32 v[16:17], v[142:143], v[94:95], v[16:17]
  v_pk_fma_f32 v[18:19], v[142:143], v[110:111], v[18:19]
  v_add_f32 v14, v16, v17
  v_add_f32 v15, v18, v19
  s_nop 1
  v_permlane32_swap_b32 v14, v15
  s_nop 1
  v_add_f32 v14, v14, v15
  v_cmp_eq_u32 vcc, -1, v14
  v_mov_b32 v15, 0x7fc00000
  s_nop 1
  v_cndmask_b32 v14, v14, v15, vcc
  s_waitcnt vmcnt(0)
  v_cmp_eq_u32 s[36:37], -1, v144
  v_cmp_eq_u32 s[38:39], -1, v145
  v_cmp_eq_u32 vcc, -1, v146
  s_nop 3
  s_or_b64 s[36:37], s[36:37], s[38:39]
  s_or_b64 s[36:37], s[36:37], vcc
  s_cbranch_scc1 L_publish
  s_branch L_fdone
L_publish:
  s_lshl_b32 s22, s21, 10
  v_add_u32 v10, s22, v148
  global_store_dword v10, v14, s[44:45] sc1
  global_load_dword v144, v149, s[44:45] sc1
  global_load_dword v145, v150, s[44:45] sc1
  global_load_dword v146, v151, s[44:45] sc1
  s_waitcnt vmcnt(0)
  v_cmp_eq_u32 s[36:37], -1, v144
  v_cmp_eq_u32 s[38:39], -1, v145
  v_cmp_eq_u32 vcc, -1, v146
  s_nop 3
  s_or_b64 s[36:37], s[36:37], s[38:39]
  s_or_b64 s[36:37], s[36:37], vcc
  s_cbranch_scc1 L_again
  s_branch L_fdone
L_again:
  global_load_dword v144, v149, s[44:45] sc1
  global_load_dword v145, v150, s[44:45] sc1
  global_load_dword v146, v151, s[44:45] sc1
  s_waitcnt vmcnt(0)
  v_cmp_eq_u32 s[36:37], -1, v144
  v_cmp_eq_u32 s[38:39], -1, v145
  v_cmp_eq_u32 vcc, -1, v146
  s_nop 3
  s_or_b64 s[36:37], s[36:37], s[38:39]
  s_or_b64 s[36:37], s[36:37], vcc
  s_cbranch_scc1 L_stamp
L_fdone:
  s_cmp_lg_u32 s21, 0
  s_cbranch_scc1 L_fs0
  v_add_f32 v24, v14, v144
  v_add_f32 v24, v24, v145
  v_add_f32 v24, v24, v146
  s_branch L_fsum
L_fs0:
  s_cmp_lg_u32 s21, 1
  s_cbranch_scc1 L_fs1
  v_add_f32 v24, v146, v14
  v_add_f32 v24, v24, v144
  v_add_f32 v24, v24, v145
  s_branch L_fsum
L_fs1:
  s_cmp_lg_u32 s21, 2
  s_cbranch_scc1 L_fs2
  v_add_f32 v24, v145, v146
  v_add_f32 v24, v24, v14
  v_add_f32 v24, v24, v144
  s_branch L_fsum
L_fs2:
  v_add_f32 v24, v144, v145
  v_add_f32 v24, v24, v146
  v_add_f32 v24, v24, v14
L_fsum:
  v_cvt_pk_bf16_f32 v24, v24, v24
  s_lshl_b32 s22, s20, 9
  s_lshl_b32 s49, s3, 7
  s_add_u32 s22, s22, s49
  v_lshl_add_u32 v10, v1, 1, s22
  global_store_short v10, v24, s[40:41]
L_stamp:
  s_endpgm
L_helper:
  s_setprio 3
  s_load_dwordx2 s[40:41], s[0:1], 0
  s_load_dwordx4 s[44:47], s[0:1], 48
  s_waitcnt lgkmcnt(0)
  s_lshl_b32 s22, s20, 9
  v_lshl_add_u32 v10, v1, 3, s22
  global_load_dwordx2 v[12:13], v10, s[40:41]
  s_lshl_b32 s22, s20, 12
  s_lshl_b32 s23, s21, 10
  s_add_u32 s22, s22, s23
  s_add_u32 s22, s22, 65536
  v_lshl_add_u32 v11, v1, 4, s22
  v_mov_b32 v16, -1
  v_mov_b32 v17, -1
  v_mov_b32 v18, -1
  v_mov_b32 v19, -1
  global_store_dwordx4 v11, v[16:19], s[46:47] sc1
  s_cmp_ge_u32 s21, 2
  s_cbranch_scc1 L_hnz2
  s_lshl_b32 s22, s20, 1
  s_add_u32 s22, s22, s21
  s_lshl_b32 s22, s22, 8
  s_add_u32 s22, s22, 327680
  v_lshl_add_u32 v20, v1, 2, s22
  v_mov_b32 v21, 0
  global_store_dword v20, v21, s[46:47] sc1
L_hnz2:
  s_load_dwordx2 s[56:57], s[0:1], 32
  s_lshl_b32 s23, s2, 12
  v_lshl_add_u32 v22, v1, 4, s23
  s_waitcnt lgkmcnt(0)
  global_load_dwordx4 v[24:27], v22, s[56:57] offset:0
  global_load_dwordx4 v[28:31], v22, s[56:57] offset:1024
  global_load_dwordx4 v[32:35], v22, s[56:57] offset:2048
  global_load_dwordx4 v[36:39], v22, s[56:57] offset:3072
  s_barrier
  s_waitcnt vmcnt(0)
  v_lshlrev_b32 v16, 16, v12
  v_and_b32 v17, 0xffff0000, v12
  v_lshlrev_b32 v18, 16, v13
  v_and_b32 v19, 0xffff0000, v13
  v_lshlrev_b32 v10, 4, v1
  ds_write_b128 v10, v[16:19] offset:0
  v_lshlrev_b32 v10, 2, v1
  v_mov_b32 v15, 1
  s_waitcnt lgkmcnt(0)
  ds_write_b32 v10, v15 offset:4864
  v_and_b32 v11, 3, v1
  v_lshlrev_b32 v11, 8, v11
  s_mov_b32 s38, 0
L_hk:
  s_sleep 8
  ds_read_b32 v12, v11 offset:3840
  s_waitcnt lgkmcnt(0)
  v_cmp_eq_u32 vcc, 0, v12
  s_add_u32 s38, s38, 1
  s_nop 3
  s_cmp_eq_u64 vcc, 0
  s_cbranch_scc1 L_hk1
  s_cmp_lt_u32 s38, 4194304
  s_cbranch_scc1 L_hk
L_hk1:
  ds_read_b32 v12, v10 offset:1024
  ds_read_b32 v13, v10 offset:1280
  ds_read_b32 v14, v10 offset:1536
  ds_read_b32 v15, v10 offset:1792
  s_waitcnt lgkmcnt(0)
  v_add_f32 v12, v12, v13
  v_add_f32 v14, v14, v15
  v_add_f32 v12, v12, v14
  s_lshl_b32 s22, s20, 10
  s_add_u32 s22, s22, 0
  s_lshl_b32 s23, s21, 8
  s_add_u32 s23, s23, s22
  v_add_u32 v11, s23, v10
  global_store_dword v11, v12, s[46:47] sc1
  s_lshl_b32 s23, s20, 2
  s_add_u32 s48, s44, s23
  s_addc_u32 s49, s45, 0
  s_mov_b32 s36, 1
  s_waitcnt vmcnt(0)
  s_atomic_add s36, s[48:49], 0x0 glc
  s_waitcnt lgkmcnt(0)
  s_add_u32 s36, s36, 1
  s_mov_b32 s35, 0
L_hpoll:
  s_cmp_ge_u32 s36, 4
  s_cbranch_scc1 L_hgot
  s_sleep 32
  s_mov_b32 s36, 0
  s_atomic_add s36, s[48:49], 0x0 glc
  s_waitcnt lgkmcnt(0)
  s_add_u32 s35, s35, 1
  s_cmp_lt_u32 s35, 0x10000
  s_cbranch_scc1 L_hpoll
L_hgot:
  v_add_u32 v11, s22, v10
  global_load_dword v12, v11, s[46:47] offset:0 sc1
  global_load_dword v13, v11, s[46:47] offset:256 sc1
  global_load_dword v14, v11, s[46:47] offset:512 sc1
  global_load_dword v15, v11, s[46:47] offset:768 sc1
  s_waitcnt vmcnt(0)
  v_add_f32 v12, v12, v13
  v_add_f32 v14, v14, v15
  v_add_f32 v12, v12, v14
  v_mul_f32 v12, 0x3db8aa3b, v12
  v_mov_b32 v13, v12
  s_nop 1
  v_max_f32_dpp v13, v13, v13 row_ror:8 row_mask:0xf bank_mask:0xf
  s_nop 1
  v_max_f32_dpp v13, v13, v13 row_ror:4 row_mask:0xf bank_mask:0xf
  s_nop 1
  v_max_f32_dpp v13, v13, v13 row_ror:2 row_mask:0xf bank_mask:0xf
  s_nop 1
  v_max_f32_dpp v13, v13, v13 row_ror:1 row_mask:0xf bank_mask:0xf
  v_mov_b32 v14, v13
  s_nop 1
  v_permlane16_swap_b32 v13, v14
  s_nop 1
  v_max_f32 v13, v13, v14
  v_mov_b32 v14, v13
  s_nop 1
  v_permlane32_swap_b32 v13, v14
  s_nop 1
  v_max_f32 v13, v13, v14
  v_sub_f32 v12, v12, v13
  v_exp_f32 v12, v12
  s_nop 1
  v_mov_b32 v13, v12
  s_nop 1
  v_add_f32_dpp v13, v13, v13 row_ror:8 row_mask:0xf bank_mask:0xf
  s_nop 1
  v_add_f32_dpp v13, v13, v13 row_ror:4 row_mask:0xf bank_mask:0xf
  s_nop 1
  v_add_f32_dpp v13, v13, v13 row_ror:2 row_mask:0xf bank_mask:0xf
  s_nop 1
  v_add_f32_dpp v13, v13, v13 row_ror:1 row_mask:0xf bank_mask:0xf
  v_mov_b32 v14, v13
  s_nop 1
  v_permlane16_swap_b32 v13, v14
  s_nop 1
  v_add_f32 v13, v13, v14
  v_mov_b32 v14, v13
  s_nop 1
  v_permlane32_swap_b32 v13, v14
  s_nop 1
  v_add_f32 v13, v13, v14
  v_rcp_f32 v13, v13
  s_nop 1
  v_mul_f32 v12, v12, v13
  ds_write_b32 v10, v12 offset:2048
  v_mov_b32 v15, 1
  s_waitcnt lgkmcnt(0)
  ds_write_b32 v10, v15 offset:5120
  s_waitcnt lgkmcnt(0)
  s_lshl_b32 s22, s20, 1
  s_and_b32 s23, s21, 1
  s_add_u32 s22, s22, s23
  s_lshl_b32 s22, s22, 8
  s_add_u32 s22, s22, 327680
  s_add_u32 s48, s46, s22
  s_addc_u32 s49, s47, 0
  v_mov_b32 v11, 5632
  v_mov_b32 v13, 5376
  s_mov_b32 s37, 28
  s_mov_b32 s30, 0
  s_mov_b32 s31, 0
  s_mov_b64 exec, 1
L_hd:
  s_mov_b32 s38, 0
L_hd0:
  ds_read_b32 v12, v11
  s_waitcnt lgkmcnt(0)
  v_readfirstlane_b32 s39, v12
  s_add_u32 s38, s38, 1
  s_cmp_ge_u32 s39, s37
  s_cbranch_scc1 L_hd1
  s_sleep 1
  s_cmp_lt_u32 s38, 4194304
  s_cbranch_scc1 L_hd0
L_hd1:
  s_mov_b32 s36, 1
  s_atomic_add s36, s[48:49], 0x0 glc
  s_waitcnt lgkmcnt(0)
  s_cmp_ge_u32 s36, 4
  s_cbranch_scc1 L_hdend
  s_cmp_ge_u32 s30, 2
  s_cbranch_scc1 L_hdsteal
  s_lshl_b32 s35, s21, 5
  s_add_u32 s35, s35, s30
  s_add_u32 s35, s35, 31
  s_add_u32 s30, s30, 1
  s_branch L_hdput
L_hdsteal:
  s_xor_b32 s35, s21, 2
  s_lshl_b32 s35, s35, 5
  s_add_u32 s35, s35, 32
  s_sub_u32 s35, s35, s31
  s_add_u32 s31, s31, 1
L_hdput:
  v_mov_b32 v12, s35
  ds_write_b32 v13, v12
  v_add_u32 v13, 4, v13
  s_add_u32 s37, s37, 1
  s_branch L_hd
L_hdend:
  v_mov_b32 v12, 0x1000
  ds_write_b32 v13, v12
  s_waitcnt lgkmcnt(0)
L_end:
  s_endpgm
.section .rodata,"a"
.p2align 6
.amdhsa_kernel standalone__low_rank_proj_linformer__decode_kernel
  .amdhsa_next_free_vgpr 152
  .amdhsa_next_free_sgpr 96
  .amdhsa_accum_offset 152
  .amdhsa_group_segment_fixed_size 0
  .amdhsa_kernarg_size 64
  .amdhsa_user_sgpr_count 2
  .amdhsa_user_sgpr_kernarg_segment_ptr 1
  .amdhsa_system_sgpr_workgroup_id_x 1
.end_amdhsa_kernel
```
